```python
import torch

def _softmax(x, axis=-1):
    return torch.softmax(x, dim=axis)
def _gelu(x):
    return torch.nn.functional.gelu(x, approximate="tanh")
def _silu(x):
    return torch.nn.functional.silu(x)
def _sigmoid(x):
    return torch.sigmoid(x)
def _layernorm(x, axis=-1, eps=1e-5):
    m = x.mean(dim=axis, keepdim=True)
    v = x.var(dim=axis, keepdim=True, unbiased=False)
    return (x - m) / torch.sqrt(v + eps)
def _scatter_add(tgt, idx, src, axis=0):
    return tgt.clone().index_add_(axis, idx, src)
def _segment_sum(src, seg, n):
    out = torch.zeros((n,) + src.shape[1:], dtype=src.dtype)
    return out.index_add_(0, seg, src)
def _pad(x, pw):
    flat = tuple(v for pair in reversed(pw) for v in pair)
    return torch.nn.functional.pad(x, flat)

kernel_name = 'standalone__channel_attn_eca__vision'

def setup_inputs():

    _w = (lambda a: (lambda t: t.to(torch.bfloat16) if t.is_floating_point() else t)(torch.as_tensor(a)))
    H = W = 512
    C = 192
    k = 1
    return {
        "x": _w((lambda *s: torch.randn(*s, dtype=torch.bfloat16) * 0.4)(1, H, W, C) + (lambda *s: torch.randn(*s, dtype=torch.bfloat16) * 0.4)(1, 1, 1, C) * 2.0),
        "w1d": _w((lambda *s: torch.randn(*s, dtype=torch.bfloat16) * 0.4)(k)),
    }

def reference(x, w1d):
    B, H, W, C = x.shape
    k = 1
    pad = k // 2
    g = torch.einsum("bhwc->bc", x) / (H * W)
    gp = _pad(g, ((0, 0), (pad, pad)))
    s = torch.zeros_like(g)
    for i in range(k):
        s = s + gp[:, i:i + C] * w1d[i]
    s = _sigmoid(s)
    return x * s[:, None, None, :]
```

```asm
; @launch grid=(256,1,1) block=(768,1,1) lds=4032
.amdgcn_target "amdgcn-amd-amdhsa--gfx950"
.text
.globl standalone__channel_attn_eca__vision_kernel
.p2align 8
.type standalone__channel_attn_eca__vision_kernel,@function
standalone__channel_attn_eca__vision_kernel:
  s_cmp_ge_u32 s2, 256
  s_cbranch_scc1 L_end
  s_load_dwordx2 s[16:17], s[0:1], 0
  s_load_dwordx2 s[20:21], s[0:1], 16
  s_load_dwordx2 s[28:29], s[0:1], 32
  s_load_dwordx2 s[32:33], s[0:1], 8
  v_lshrrev_b32 v2, 6, v0
  v_and_b32 v3, 63, v0
  v_lshrrev_b32 v4, 3, v3
  v_readfirstlane_b32 s14, v2
  v_and_b32 v5, 7, v3
  v_mul_u32_u24 v6, 0x180, v4
  v_lshl_add_u32 v1, v5, 4, v6
  v_mov_b32 v7, 0
  s_lshr_b32 s44, s14, 2
  s_and_b32 s45, s14, 3
  s_mov_b32 s18, 100663296
  s_mov_b32 s19, 0x20000
  s_mul_i32 s37, s2, 12288
  s_mul_i32 s38, s45, 3072
  s_add_u32 s37, s37, s38
  s_lshl_b32 s38, s44, 7
  s_add_u32 s37, s37, s38
  s_cmp_eq_u32 s14, 0
  s_cbranch_scc0 L_noinit
  v_lshlrev_b32 v6, 2, v3
  s_mov_b64 exec, 0xffff
  ds_write_b32 v6, v7 offset:3968
  s_mov_b64 exec, -1
  s_waitcnt lgkmcnt(0)
L_noinit:
  s_barrier
  s_mov_b32 s36, 0xffff0000
  s_waitcnt lgkmcnt(0)
  s_lshl_b32 s47, s45, 2
  v_mov_b32 v167, s47
  s_mov_b32 s38, s37
  s_mov_b32 s46, 3145728
  buffer_load_dwordx4 v[32:35], v1, s[16:19], s38 offen nt
  s_add_u32 s38, s38, s46
  buffer_load_dwordx4 v[36:39], v1, s[16:19], s38 offen nt
  s_add_u32 s38, s38, s46
  buffer_load_dwordx4 v[40:43], v1, s[16:19], s38 offen nt
  s_add_u32 s38, s38, s46
  buffer_load_dwordx4 v[44:47], v1, s[16:19], s38 offen nt
  s_add_u32 s38, s38, s46
  buffer_load_dwordx4 v[48:51], v1, s[16:19], s38 offen nt
  s_add_u32 s38, s38, s46
  s_waitcnt vmcnt(4)
  buffer_load_dwordx4 v[52:55], v1, s[16:19], s38 offen nt
  s_add_u32 s38, s38, s46
  v_lshlrev_b32 v8, 16, v32
  v_and_b32 v9, s36, v32
  v_lshlrev_b32 v10, 16, v33
  v_and_b32 v11, s36, v33
  v_lshlrev_b32 v12, 16, v34
  v_and_b32 v13, s36, v34
  v_lshlrev_b32 v14, 16, v35
  v_and_b32 v15, s36, v35
  s_waitcnt vmcnt(4)
  buffer_load_dwordx4 v[56:59], v1, s[16:19], s38 offen nt
  s_add_u32 s38, s38, s46
  v_lshlrev_b32 v16, 16, v36
  v_and_b32 v17, s36, v36
  v_add_f32 v8, v8, v16
  v_add_f32 v9, v9, v17
  v_lshlrev_b32 v18, 16, v37
  v_and_b32 v19, s36, v37
  v_add_f32 v10, v10, v18
  v_add_f32 v11, v11, v19
  v_lshlrev_b32 v20, 16, v38
  v_and_b32 v21, s36, v38
  v_add_f32 v12, v12, v20
  v_add_f32 v13, v13, v21
  v_lshlrev_b32 v22, 16, v39
  v_and_b32 v23, s36, v39
  v_add_f32 v14, v14, v22
  v_add_f32 v15, v15, v23
  s_waitcnt vmcnt(4)
  buffer_load_dwordx4 v[60:63], v1, s[16:19], s38 offen nt
  s_add_u32 s38, s38, s46
  v_lshlrev_b32 v16, 16, v40
  v_and_b32 v17, s36, v40
  v_add_f32 v8, v8, v16
  v_add_f32 v9, v9, v17
  v_lshlrev_b32 v18, 16, v41
  v_and_b32 v19, s36, v41
  v_add_f32 v10, v10, v18
  v_add_f32 v11, v11, v19
  v_lshlrev_b32 v20, 16, v42
  v_and_b32 v21, s36, v42
  v_add_f32 v12, v12, v20
  v_add_f32 v13, v13, v21
  v_lshlrev_b32 v22, 16, v43
  v_and_b32 v23, s36, v43
  v_add_f32 v14, v14, v22
  v_add_f32 v15, v15, v23
  s_waitcnt vmcnt(4)
  buffer_load_dwordx4 v[64:67], v1, s[16:19], s38 offen nt
  s_add_u32 s38, s38, s46
  v_lshlrev_b32 v16, 16, v44
  v_and_b32 v17, s36, v44
  v_add_f32 v8, v8, v16
  v_add_f32 v9, v9, v17
  v_lshlrev_b32 v18, 16, v45
  v_and_b32 v19, s36, v45
  v_add_f32 v10, v10, v18
  v_add_f32 v11, v11, v19
  v_lshlrev_b32 v20, 16, v46
  v_and_b32 v21, s36, v46
  v_add_f32 v12, v12, v20
  v_add_f32 v13, v13, v21
  v_lshlrev_b32 v22, 16, v47
  v_and_b32 v23, s36, v47
  v_add_f32 v14, v14, v22
  v_add_f32 v15, v15, v23
  s_waitcnt vmcnt(4)
  buffer_load_dwordx4 v[68:71], v1, s[16:19], s38 offen nt
  s_add_u32 s38, s38, s46
  v_lshlrev_b32 v16, 16, v48
  v_and_b32 v17, s36, v48
  v_add_f32 v8, v8, v16
  v_add_f32 v9, v9, v17
  v_lshlrev_b32 v18, 16, v49
  v_and_b32 v19, s36, v49
  v_add_f32 v10, v10, v18
  v_add_f32 v11, v11, v19
  v_lshlrev_b32 v20, 16, v50
  v_and_b32 v21, s36, v50
  v_add_f32 v12, v12, v20
  v_add_f32 v13, v13, v21
  v_lshlrev_b32 v22, 16, v51
  v_and_b32 v23, s36, v51
  v_add_f32 v14, v14, v22
  v_add_f32 v15, v15, v23
  s_waitcnt vmcnt(4)
  buffer_load_dwordx4 v[72:75], v1, s[16:19], s38 offen nt
  s_add_u32 s38, s38, s46
  v_lshlrev_b32 v16, 16, v52
  v_and_b32 v17, s36, v52
  v_add_f32 v8, v8, v16
  v_add_f32 v9, v9, v17
  v_lshlrev_b32 v18, 16, v53
  v_and_b32 v19, s36, v53
  v_add_f32 v10, v10, v18
  v_add_f32 v11, v11, v19
  v_lshlrev_b32 v20, 16, v54
  v_and_b32 v21, s36, v54
  v_add_f32 v12, v12, v20
  v_add_f32 v13, v13, v21
  v_lshlrev_b32 v22, 16, v55
  v_and_b32 v23, s36, v55
  v_add_f32 v14, v14, v22
  v_add_f32 v15, v15, v23
  s_waitcnt vmcnt(4)
  buffer_load_dwordx4 v[76:79], v1, s[16:19], s38 offen nt
  s_add_u32 s38, s38, s46
  v_lshlrev_b32 v16, 16, v56
  v_and_b32 v17, s36, v56
  v_add_f32 v8, v8, v16
  v_add_f32 v9, v9, v17
  v_lshlrev_b32 v18, 16, v57
  v_and_b32 v19, s36, v57
  v_add_f32 v10, v10, v18
  v_add_f32 v11, v11, v19
  v_lshlrev_b32 v20, 16, v58
  v_and_b32 v21, s36, v58
  v_add_f32 v12, v12, v20
  v_add_f32 v13, v13, v21
  v_lshlrev_b32 v22, 16, v59
  v_and_b32 v23, s36, v59
  v_add_f32 v14, v14, v22
  v_add_f32 v15, v15, v23
  s_waitcnt vmcnt(4)
  buffer_load_dwordx4 v[80:83], v1, s[16:19], s38 offen nt
  s_add_u32 s38, s38, s46
  v_lshlrev_b32 v16, 16, v60
  v_and_b32 v17, s36, v60
  v_add_f32 v8, v8, v16
  v_add_f32 v9, v9, v17
  v_lshlrev_b32 v18, 16, v61
  v_and_b32 v19, s36, v61
  v_add_f32 v10, v10, v18
  v_add_f32 v11, v11, v19
  v_lshlrev_b32 v20, 16, v62
  v_and_b32 v21, s36, v62
  v_add_f32 v12, v12, v20
  v_add_f32 v13, v13, v21
  v_lshlrev_b32 v22, 16, v63
  v_and_b32 v23, s36, v63
  v_add_f32 v14, v14, v22
  v_add_f32 v15, v15, v23
  s_waitcnt vmcnt(4)
  buffer_load_dwordx4 v[84:87], v1, s[16:19], s38 offen nt
  s_add_u32 s38, s38, s46
  v_lshlrev_b32 v16, 16, v64
  v_and_b32 v17, s36, v64
  v_add_f32 v8, v8, v16
  v_add_f32 v9, v9, v17
  v_lshlrev_b32 v18, 16, v65
  v_and_b32 v19, s36, v65
  v_add_f32 v10, v10, v18
  v_add_f32 v11, v11, v19
  v_lshlrev_b32 v20, 16, v66
  v_and_b32 v21, s36, v66
  v_add_f32 v12, v12, v20
  v_add_f32 v13, v13, v21
  v_lshlrev_b32 v22, 16, v67
  v_and_b32 v23, s36, v67
  v_add_f32 v14, v14, v22
  v_add_f32 v15, v15, v23
  s_waitcnt vmcnt(4)
  buffer_load_dwordx4 v[88:91], v1, s[16:19], s38 offen nt
  s_add_u32 s38, s38, s46
  v_lshlrev_b32 v16, 16, v68
  v_and_b32 v17, s36, v68
  v_add_f32 v8, v8, v16
  v_add_f32 v9, v9, v17
  v_lshlrev_b32 v18, 16, v69
  v_and_b32 v19, s36, v69
  v_add_f32 v10, v10, v18
  v_add_f32 v11, v11, v19
  v_lshlrev_b32 v20, 16, v70
  v_and_b32 v21, s36, v70
  v_add_f32 v12, v12, v20
  v_add_f32 v13, v13, v21
  v_lshlrev_b32 v22, 16, v71
  v_and_b32 v23, s36, v71
  v_add_f32 v14, v14, v22
  v_add_f32 v15, v15, v23
  s_waitcnt vmcnt(4)
  buffer_load_dwordx4 v[92:95], v1, s[16:19], s38 offen nt
  s_add_u32 s38, s38, s46
  v_lshlrev_b32 v16, 16, v72
  v_and_b32 v17, s36, v72
  v_add_f32 v8, v8, v16
  v_add_f32 v9, v9, v17
  v_lshlrev_b32 v18, 16, v73
  v_and_b32 v19, s36, v73
  v_add_f32 v10, v10, v18
  v_add_f32 v11, v11, v19
  v_lshlrev_b32 v20, 16, v74
  v_and_b32 v21, s36, v74
  v_add_f32 v12, v12, v20
  v_add_f32 v13, v13, v21
  v_lshlrev_b32 v22, 16, v75
  v_and_b32 v23, s36, v75
  v_add_f32 v14, v14, v22
  v_add_f32 v15, v15, v23
  s_waitcnt vmcnt(4)
  buffer_load_dwordx4 v[96:99], v1, s[16:19], s38 offen nt
  s_add_u32 s38, s38, s46
  v_lshlrev_b32 v16, 16, v76
  v_and_b32 v17, s36, v76
  v_add_f32 v8, v8, v16
  v_add_f32 v9, v9, v17
  v_lshlrev_b32 v18, 16, v77
  v_and_b32 v19, s36, v77
  v_add_f32 v10, v10, v18
  v_add_f32 v11, v11, v19
  v_lshlrev_b32 v20, 16, v78
  v_and_b32 v21, s36, v78
  v_add_f32 v12, v12, v20
  v_add_f32 v13, v13, v21
  v_lshlrev_b32 v22, 16, v79
  v_and_b32 v23, s36, v79
  v_add_f32 v14, v14, v22
  v_add_f32 v15, v15, v23
  s_waitcnt vmcnt(4)
  buffer_load_dwordx4 v[100:103], v1, s[16:19], s38 offen nt
  s_add_u32 s38, s38, s46
  v_lshlrev_b32 v16, 16, v80
  v_and_b32 v17, s36, v80
  v_add_f32 v8, v8, v16
  v_add_f32 v9, v9, v17
  v_lshlrev_b32 v18, 16, v81
  v_and_b32 v19, s36, v81
  v_add_f32 v10, v10, v18
  v_add_f32 v11, v11, v19
  v_lshlrev_b32 v20, 16, v82
  v_and_b32 v21, s36, v82
  v_add_f32 v12, v12, v20
  v_add_f32 v13, v13, v21
  v_lshlrev_b32 v22, 16, v83
  v_and_b32 v23, s36, v83
  v_add_f32 v14, v14, v22
  v_add_f32 v15, v15, v23
  s_waitcnt vmcnt(4)
  buffer_load_dwordx4 v[104:107], v1, s[16:19], s38 offen nt
  s_add_u32 s38, s38, s46
  v_lshlrev_b32 v16, 16, v84
  v_and_b32 v17, s36, v84
  v_add_f32 v8, v8, v16
  v_add_f32 v9, v9, v17
  v_lshlrev_b32 v18, 16, v85
  v_and_b32 v19, s36, v85
  v_add_f32 v10, v10, v18
  v_add_f32 v11, v11, v19
  v_lshlrev_b32 v20, 16, v86
  v_and_b32 v21, s36, v86
  v_add_f32 v12, v12, v20
  v_add_f32 v13, v13, v21
  v_lshlrev_b32 v22, 16, v87
  v_and_b32 v23, s36, v87
  v_add_f32 v14, v14, v22
  v_add_f32 v15, v15, v23
  s_waitcnt vmcnt(4)
  buffer_load_dwordx4 v[108:111], v1, s[16:19], s38 offen nt
  s_add_u32 s38, s38, s46
  v_lshlrev_b32 v16, 16, v88
  v_and_b32 v17, s36, v88
  v_add_f32 v8, v8, v16
  v_add_f32 v9, v9, v17
  v_lshlrev_b32 v18, 16, v89
  v_and_b32 v19, s36, v89
  v_add_f32 v10, v10, v18
  v_add_f32 v11, v11, v19
  v_lshlrev_b32 v20, 16, v90
  v_and_b32 v21, s36, v90
  v_add_f32 v12, v12, v20
  v_add_f32 v13, v13, v21
  v_lshlrev_b32 v22, 16, v91
  v_and_b32 v23, s36, v91
  v_add_f32 v14, v14, v22
  v_add_f32 v15, v15, v23
  s_waitcnt vmcnt(4)
  buffer_load_dwordx4 v[112:115], v1, s[16:19], s38 offen nt
  s_add_u32 s38, s38, s46
  v_lshlrev_b32 v16, 16, v92
  v_and_b32 v17, s36, v92
  v_add_f32 v8, v8, v16
  v_add_f32 v9, v9, v17
  v_lshlrev_b32 v18, 16, v93
  v_and_b32 v19, s36, v93
  v_add_f32 v10, v10, v18
  v_add_f32 v11, v11, v19
  v_lshlrev_b32 v20, 16, v94
  v_and_b32 v21, s36, v94
  v_add_f32 v12, v12, v20
  v_add_f32 v13, v13, v21
  v_lshlrev_b32 v22, 16, v95
  v_and_b32 v23, s36, v95
  v_add_f32 v14, v14, v22
  v_add_f32 v15, v15, v23
  s_waitcnt vmcnt(4)
  buffer_load_dwordx4 v[116:119], v1, s[16:19], s38 offen nt
  s_add_u32 s38, s38, s46
  v_lshlrev_b32 v16, 16, v96
  v_and_b32 v17, s36, v96
  v_add_f32 v8, v8, v16
  v_add_f32 v9, v9, v17
  v_lshlrev_b32 v18, 16, v97
  v_and_b32 v19, s36, v97
  v_add_f32 v10, v10, v18
  v_add_f32 v11, v11, v19
  v_lshlrev_b32 v20, 16, v98
  v_and_b32 v21, s36, v98
  v_add_f32 v12, v12, v20
  v_add_f32 v13, v13, v21
  v_lshlrev_b32 v22, 16, v99
  v_and_b32 v23, s36, v99
  v_add_f32 v14, v14, v22
  v_add_f32 v15, v15, v23
  s_waitcnt vmcnt(4)
  buffer_load_dwordx4 v[120:123], v1, s[16:19], s38 offen nt
  s_add_u32 s38, s38, s46
  v_lshlrev_b32 v16, 16, v100
  v_and_b32 v17, s36, v100
  v_add_f32 v8, v8, v16
  v_add_f32 v9, v9, v17
  v_lshlrev_b32 v18, 16, v101
  v_and_b32 v19, s36, v101
  v_add_f32 v10, v10, v18
  v_add_f32 v11, v11, v19
  v_lshlrev_b32 v20, 16, v102
  v_and_b32 v21, s36, v102
  v_add_f32 v12, v12, v20
  v_add_f32 v13, v13, v21
  v_lshlrev_b32 v22, 16, v103
  v_and_b32 v23, s36, v103
  v_add_f32 v14, v14, v22
  v_add_f32 v15, v15, v23
  s_waitcnt vmcnt(4)
  buffer_load_dwordx4 v[124:127], v1, s[16:19], s38 offen nt
  s_add_u32 s38, s38, s46
  v_lshlrev_b32 v16, 16, v104
  v_and_b32 v17, s36, v104
  v_add_f32 v8, v8, v16
  v_add_f32 v9, v9, v17
  v_lshlrev_b32 v18, 16, v105
  v_and_b32 v19, s36, v105
  v_add_f32 v10, v10, v18
  v_add_f32 v11, v11, v19
  v_lshlrev_b32 v20, 16, v106
  v_and_b32 v21, s36, v106
  v_add_f32 v12, v12, v20
  v_add_f32 v13, v13, v21
  v_lshlrev_b32 v22, 16, v107
  v_and_b32 v23, s36, v107
  v_add_f32 v14, v14, v22
  v_add_f32 v15, v15, v23
  s_waitcnt vmcnt(4)
  buffer_load_dwordx4 v[128:131], v1, s[16:19], s38 offen nt
  s_add_u32 s38, s38, s46
  v_lshlrev_b32 v16, 16, v108
  v_and_b32 v17, s36, v108
  v_add_f32 v8, v8, v16
  v_add_f32 v9, v9, v17
  v_lshlrev_b32 v18, 16, v109
  v_and_b32 v19, s36, v109
  v_add_f32 v10, v10, v18
  v_add_f32 v11, v11, v19
  v_lshlrev_b32 v20, 16, v110
  v_and_b32 v21, s36, v110
  v_add_f32 v12, v12, v20
  v_add_f32 v13, v13, v21
  v_lshlrev_b32 v22, 16, v111
  v_and_b32 v23, s36, v111
  v_add_f32 v14, v14, v22
  v_add_f32 v15, v15, v23
  s_waitcnt vmcnt(4)
  buffer_load_dwordx4 v[132:135], v1, s[16:19], s38 offen nt
  s_add_u32 s38, s38, s46
  v_lshlrev_b32 v16, 16, v112
  v_and_b32 v17, s36, v112
  v_add_f32 v8, v8, v16
  v_add_f32 v9, v9, v17
  v_lshlrev_b32 v18, 16, v113
  v_and_b32 v19, s36, v113
  v_add_f32 v10, v10, v18
  v_add_f32 v11, v11, v19
  v_lshlrev_b32 v20, 16, v114
  v_and_b32 v21, s36, v114
  v_add_f32 v12, v12, v20
  v_add_f32 v13, v13, v21
  v_lshlrev_b32 v22, 16, v115
  v_and_b32 v23, s36, v115
  v_add_f32 v14, v14, v22
  v_add_f32 v15, v15, v23
  s_waitcnt vmcnt(4)
  buffer_load_dwordx4 v[136:139], v1, s[16:19], s38 offen nt
  s_add_u32 s38, s38, s46
  v_lshlrev_b32 v16, 16, v116
  v_and_b32 v17, s36, v116
  v_add_f32 v8, v8, v16
  v_add_f32 v9, v9, v17
  v_lshlrev_b32 v18, 16, v117
  v_and_b32 v19, s36, v117
  v_add_f32 v10, v10, v18
  v_add_f32 v11, v11, v19
  v_lshlrev_b32 v20, 16, v118
  v_and_b32 v21, s36, v118
  v_add_f32 v12, v12, v20
  v_add_f32 v13, v13, v21
  v_lshlrev_b32 v22, 16, v119
  v_and_b32 v23, s36, v119
  v_add_f32 v14, v14, v22
  v_add_f32 v15, v15, v23
  s_waitcnt vmcnt(4)
  buffer_load_dwordx4 v[140:143], v1, s[16:19], s38 offen nt
  s_add_u32 s38, s38, s46
  v_lshlrev_b32 v16, 16, v120
  v_and_b32 v17, s36, v120
  v_add_f32 v8, v8, v16
  v_add_f32 v9, v9, v17
  v_lshlrev_b32 v18, 16, v121
  v_and_b32 v19, s36, v121
  v_add_f32 v10, v10, v18
  v_add_f32 v11, v11, v19
  v_lshlrev_b32 v20, 16, v122
  v_and_b32 v21, s36, v122
  v_add_f32 v12, v12, v20
  v_add_f32 v13, v13, v21
  v_lshlrev_b32 v22, 16, v123
  v_and_b32 v23, s36, v123
  v_add_f32 v14, v14, v22
  v_add_f32 v15, v15, v23
  s_waitcnt vmcnt(4)
  buffer_load_dwordx4 v[144:147], v1, s[16:19], s38 offen nt
  s_add_u32 s38, s38, s46
  v_lshlrev_b32 v16, 16, v124
  v_and_b32 v17, s36, v124
  v_add_f32 v8, v8, v16
  v_add_f32 v9, v9, v17
  v_lshlrev_b32 v18, 16, v125
  v_and_b32 v19, s36, v125
  v_add_f32 v10, v10, v18
  v_add_f32 v11, v11, v19
  v_lshlrev_b32 v20, 16, v126
  v_and_b32 v21, s36, v126
  v_add_f32 v12, v12, v20
  v_add_f32 v13, v13, v21
  v_lshlrev_b32 v22, 16, v127
  v_and_b32 v23, s36, v127
  v_add_f32 v14, v14, v22
  v_add_f32 v15, v15, v23
  s_waitcnt vmcnt(4)
  buffer_load_dwordx4 v[148:151], v1, s[16:19], s38 offen nt
  s_add_u32 s38, s38, s46
  v_lshlrev_b32 v16, 16, v128
  v_and_b32 v17, s36, v128
  v_add_f32 v8, v8, v16
  v_add_f32 v9, v9, v17
  v_lshlrev_b32 v18, 16, v129
  v_and_b32 v19, s36, v129
  v_add_f32 v10, v10, v18
  v_add_f32 v11, v11, v19
  v_lshlrev_b32 v20, 16, v130
  v_and_b32 v21, s36, v130
  v_add_f32 v12, v12, v20
  v_add_f32 v13, v13, v21
  v_lshlrev_b32 v22, 16, v131
  v_and_b32 v23, s36, v131
  v_add_f32 v14, v14, v22
  v_add_f32 v15, v15, v23
  s_waitcnt vmcnt(4)
  buffer_load_dwordx4 v[152:155], v1, s[16:19], s38 offen nt
  s_add_u32 s38, s38, s46
  v_lshlrev_b32 v16, 16, v132
  v_and_b32 v17, s36, v132
  v_add_f32 v8, v8, v16
  v_add_f32 v9, v9, v17
  v_lshlrev_b32 v18, 16, v133
  v_and_b32 v19, s36, v133
  v_add_f32 v10, v10, v18
  v_add_f32 v11, v11, v19
  v_lshlrev_b32 v20, 16, v134
  v_and_b32 v21, s36, v134
  v_add_f32 v12, v12, v20
  v_add_f32 v13, v13, v21
  v_lshlrev_b32 v22, 16, v135
  v_and_b32 v23, s36, v135
  v_add_f32 v14, v14, v22
  v_add_f32 v15, v15, v23
  s_waitcnt vmcnt(4)
  buffer_load_dwordx4 v[156:159], v1, s[16:19], s38 offen nt
  v_lshlrev_b32 v16, 16, v136
  v_and_b32 v17, s36, v136
  v_add_f32 v8, v8, v16
  v_add_f32 v9, v9, v17
  v_lshlrev_b32 v18, 16, v137
  v_and_b32 v19, s36, v137
  v_add_f32 v10, v10, v18
  v_add_f32 v11, v11, v19
  v_lshlrev_b32 v20, 16, v138
  v_and_b32 v21, s36, v138
  v_add_f32 v12, v12, v20
  v_add_f32 v13, v13, v21
  v_lshlrev_b32 v22, 16, v139
  v_and_b32 v23, s36, v139
  v_add_f32 v14, v14, v22
  v_add_f32 v15, v15, v23
  s_mov_b32 s22, 100663296
  s_mov_b32 s23, 0x20000
  s_mov_b32 s30, 0x100000
  s_mov_b32 s31, 0x20000
  s_mov_b32 s34, 2
  s_mov_b32 s35, 0x20000
  s_mov_b32 s12, s28
  s_mov_b32 s13, s29
  s_add_u32 s54, s12, 397312
  s_addc_u32 s55, s13, 0
  s_load_dword s56, s[54:55], 0
  v_lshlrev_b32 v2, 3, v3
  s_lshl_b32 s39, s2, 9
  s_cmp_eq_u32 s44, 2
  s_cbranch_scc0 L_notg2
  v_mov_b32 v16, 1
  s_mov_b64 exec, 1
  ds_add_u32 v7, v16 offset:3992
  s_mov_b64 exec, -1
L_notg2:
  s_waitcnt vmcnt(4)
  v_lshlrev_b32 v16, 16, v140
  v_and_b32 v17, s36, v140
  v_add_f32 v8, v8, v16
  v_add_f32 v9, v9, v17
  v_lshlrev_b32 v18, 16, v141
  v_and_b32 v19, s36, v141
  v_add_f32 v10, v10, v18
  v_add_f32 v11, v11, v19
  v_lshlrev_b32 v20, 16, v142
  v_and_b32 v21, s36, v142
  v_add_f32 v12, v12, v20
  v_add_f32 v13, v13, v21
  v_lshlrev_b32 v22, 16, v143
  v_and_b32 v23, s36, v143
  v_add_f32 v14, v14, v22
  v_add_f32 v15, v15, v23
  s_waitcnt vmcnt(3)
  v_lshlrev_b32 v16, 16, v144
  v_and_b32 v17, s36, v144
  v_add_f32 v8, v8, v16
  v_add_f32 v9, v9, v17
  v_lshlrev_b32 v18, 16, v145
  v_and_b32 v19, s36, v145
  v_add_f32 v10, v10, v18
  v_add_f32 v11, v11, v19
  v_lshlrev_b32 v20, 16, v146
  v_and_b32 v21, s36, v146
  v_add_f32 v12, v12, v20
  v_add_f32 v13, v13, v21
  v_lshlrev_b32 v22, 16, v147
  v_and_b32 v23, s36, v147
  v_add_f32 v14, v14, v22
  v_add_f32 v15, v15, v23
  s_waitcnt vmcnt(2)
  v_lshlrev_b32 v16, 16, v148
  v_and_b32 v17, s36, v148
  v_add_f32 v8, v8, v16
  v_add_f32 v9, v9, v17
  v_lshlrev_b32 v18, 16, v149
  v_and_b32 v19, s36, v149
  v_add_f32 v10, v10, v18
  v_add_f32 v11, v11, v19
  v_lshlrev_b32 v20, 16, v150
  v_and_b32 v21, s36, v150
  v_add_f32 v12, v12, v20
  v_add_f32 v13, v13, v21
  v_lshlrev_b32 v22, 16, v151
  v_and_b32 v23, s36, v151
  v_add_f32 v14, v14, v22
  v_add_f32 v15, v15, v23
  s_waitcnt vmcnt(1)
  v_lshlrev_b32 v16, 16, v152
  v_and_b32 v17, s36, v152
  v_add_f32 v8, v8, v16
  v_add_f32 v9, v9, v17
  v_lshlrev_b32 v18, 16, v153
  v_and_b32 v19, s36, v153
  v_add_f32 v10, v10, v18
  v_add_f32 v11, v11, v19
  v_lshlrev_b32 v20, 16, v154
  v_and_b32 v21, s36, v154
  v_add_f32 v12, v12, v20
  v_add_f32 v13, v13, v21
  v_lshlrev_b32 v22, 16, v155
  v_and_b32 v23, s36, v155
  v_add_f32 v14, v14, v22
  v_add_f32 v15, v15, v23
  s_waitcnt vmcnt(0)
  v_lshlrev_b32 v16, 16, v156
  v_and_b32 v17, s36, v156
  v_add_f32 v8, v8, v16
  v_add_f32 v9, v9, v17
  v_lshlrev_b32 v18, 16, v157
  v_and_b32 v19, s36, v157
  v_add_f32 v10, v10, v18
  v_add_f32 v11, v11, v19
  v_lshlrev_b32 v20, 16, v158
  v_and_b32 v21, s36, v158
  v_add_f32 v12, v12, v20
  v_add_f32 v13, v13, v21
  v_lshlrev_b32 v22, 16, v159
  v_and_b32 v23, s36, v159
  v_add_f32 v14, v14, v22
  v_add_f32 v15, v15, v23
  s_waitcnt lgkmcnt(0)
  s_add_u32 s56, s56, 0x9e3779b9
  s_nop 1
  v_permlane32_swap_b32 v8, v12
  v_permlane32_swap_b32 v9, v13
  v_permlane32_swap_b32 v10, v14
  v_permlane32_swap_b32 v11, v15
  v_add_f32 v8, v8, v12
  v_add_f32 v9, v9, v13
  v_add_f32 v10, v10, v14
  v_add_f32 v11, v11, v15
  s_nop 1
  v_permlane16_swap_b32 v8, v10
  v_permlane16_swap_b32 v9, v11
  v_add_f32 v8, v8, v10
  v_add_f32 v9, v9, v11
  s_nop 1
  v_add_f32_dpp v16, v8, v8 row_ror:8 row_mask:0xf bank_mask:0x3
  v_add_f32_dpp v16, v9, v9 row_ror:8 row_mask:0xf bank_mask:0xc
  v_lshlrev_b32 v17, 2, v0
  ds_write_b32 v17, v16 offset:0
  s_lshl_b32 s47, s44, 2
  v_mov_b32 v160, s47
  v_mov_b32 v18, 1
  s_waitcnt lgkmcnt(0)
  s_mov_b64 exec, 1
  ds_add_rtn_u32 v19, v160, v18 offset:3968
  s_waitcnt lgkmcnt(0)
  s_mov_b64 exec, -1
  v_readfirstlane_b32 s41, v19
  s_cmp_eq_u32 s41, 3
  s_cbranch_scc0 L_nopub
  s_lshl_b32 s47, s44, 10
  v_lshl_add_u32 v17, v3, 2, s47
  ds_read_b32 v20, v17 offset:0
  ds_read_b32 v21, v17 offset:256
  ds_read_b32 v22, v17 offset:512
  ds_read_b32 v23, v17 offset:768
  s_waitcnt lgkmcnt(0)
  v_add_f32 v20, v20, v21
  v_add_f32 v22, v22, v23
  s_lshl_b32 s40, s44, 17
  s_add_u32 s40, s40, s39
  v_add_f32 v20, v20, v22
  v_mov_b32 v21, s56
  buffer_store_dwordx2 v[20:21], v2, s[28:31], s40 offen sc1
L_nopub:
  s_cmp_eq_u32 s14, 1
  s_cbranch_scc0 L_nodry
  s_mov_b32 s83, 1
  s_mov_b64 exec, 0
  s_branch L_storecode
L_dryback:
  s_mov_b64 exec, -1
L_nodry:
  s_mov_b32 s83, 0
  s_cmp_lt_u32 s2, 24
  s_cbranch_scc0 L_nored
  s_lshr_b32 s48, s2, 3
  s_and_b32 s49, s48, 2
  s_cmp_eq_u32 s44, s49
  s_cbranch_scc0 L_nored
  buffer_load_ushort v161, off, s[32:35], 0
  s_lshl_b32 s49, s48, 2
  v_mov_b32 v164, s49
  s_mov_b32 s42, 0
L_rw_1:
  ds_read_b32 v166, v164 offset:3968
  s_waitcnt lgkmcnt(0)
  v_readfirstlane_b32 s41, v166
  s_cmp_ge_u32 s41, 4
  s_cbranch_scc1 L_rwok_2
  s_sleep 1
  s_add_u32 s42, s42, 1
  s_cmp_lt_u32 s42, 0x400000
  s_cbranch_scc1 L_rw_1
L_rwok_2:
  s_and_b32 s49, s2, 7
  s_lshl_b32 s50, s48, 17
  s_lshl_b32 s51, s49, 6
  s_add_u32 s50, s50, s51
  s_lshl_b32 s51, s45, 15
  s_add_u32 s50, s50, s51
  s_add_u32 s57, s50, 8192
  s_add_u32 s58, s50, 16384
  s_add_u32 s59, s50, 24576
  v_lshrrev_b32 v162, 2, v3
  v_lshlrev_b32 v162, 9, v162
  v_and_b32 v163, 3, v3
  v_lshl_add_u32 v162, v163, 4, v162
  s_mov_b32 s42, 0
L_rpoll:
  buffer_load_dwordx4 v[16:19], v162, s[28:31], s50 offen sc1
  buffer_load_dwordx4 v[20:23], v162, s[28:31], s57 offen sc1
  buffer_load_dwordx4 v[24:27], v162, s[28:31], s58 offen sc1
  buffer_load_dwordx4 v[28:31], v162, s[28:31], s59 offen sc1
  s_waitcnt vmcnt(0)
  v_xor_b32 v17, s56, v17
  v_xor_b32 v19, s56, v19
  v_xor_b32 v21, s56, v21
  v_xor_b32 v23, s56, v23
  v_xor_b32 v25, s56, v25
  v_xor_b32 v27, s56, v27
  v_xor_b32 v29, s56, v29
  v_xor_b32 v31, s56, v31
  v_or3_b32 v163, v17, v19, v21
  v_or3_b32 v163, v163, v23, v25
  v_or3_b32 v163, v163, v27, v29
  v_or_b32 v163, v163, v31
  v_cmp_ne_u32 vcc, 0, v163
  s_cbranch_vccz L_rok
  s_mov_b64 exec, vcc
  s_sleep 4
  s_add_u32 s42, s42, 1
  s_cmp_lt_u32 s42, 0x20000
  s_cbranch_scc1 L_rpoll
L_rok:
  s_mov_b64 exec, -1
  v_add_f32 v16, v16, v20
  v_add_f32 v18, v18, v22
  v_add_f32 v24, v24, v28
  v_add_f32 v26, v26, v30
  v_add_f32 v16, v16, v24
  v_add_f32 v18, v18, v26
  s_nop 1
  v_add_f32_dpp v16, v16, v16 row_ror:8 row_mask:0xf bank_mask:0xf
  v_add_f32_dpp v18, v18, v18 row_ror:8 row_mask:0xf bank_mask:0xf
  s_nop 1
  v_add_f32_dpp v16, v16, v16 row_ror:4 row_mask:0xf bank_mask:0xf
  v_add_f32_dpp v18, v18, v18 row_ror:4 row_mask:0xf bank_mask:0xf
  s_nop 1
  v_permlane32_swap_b32 v16, v18
  v_add_f32 v16, v16, v18
  v_mov_b32 v17, v16
  s_nop 1
  v_permlane16_swap_b32 v16, v17
  v_add_f32 v16, v16, v17
  v_and_b32 v17, 3, v3
  v_lshlrev_b32 v17, 3, v17
  v_lshrrev_b32 v18, 5, v3
  v_lshl_add_u32 v17, v18, 2, v17
  s_lshl_b32 s50, s45, 5
  v_add_u32 v17, s50, v17
  v_mov_b32 v18, 1
  s_mov_b32 exec_lo, 0xf
  s_mov_b32 exec_hi, 0xf
  ds_write_b32 v17, v16 offset:3840
  s_waitcnt lgkmcnt(0)
  s_mov_b64 exec, 1
  ds_add_rtn_u32 v19, v7, v18 offset:4016
  s_waitcnt lgkmcnt(0)
  s_mov_b64 exec, -1
  v_readfirstlane_b32 s41, v19
  s_cmp_eq_u32 s41, 3
  s_cbranch_scc0 L_nored
  v_and_b32 v18, 7, v3
  v_lshlrev_b32 v18, 2, v18
  ds_read_b32 v20, v18 offset:3840
  ds_read_b32 v21, v18 offset:3872
  ds_read_b32 v22, v18 offset:3904
  ds_read_b32 v23, v18 offset:3936
  v_lshlrev_b32 v161, 16, v161
  s_mov_b32 s52, 0x36800000
  s_mov_b32 s53, 0xbfb8aa3b
  s_lshl_b32 s50, s2, 7
  s_add_u32 s50, s50, 393216
  s_waitcnt lgkmcnt(0)
  v_add_f32 v20, v20, v21
  v_add_f32 v22, v22, v23
  v_add_f32 v16, v20, v22
  v_cvt_pk_bf16_f32 v16, v16, v16
  v_and_b32 v16, s36, v16
  v_mul_f32 v16, s52, v16
  v_cvt_pk_bf16_f32 v16, v16, v16
  v_and_b32 v16, s36, v16
  v_mul_f32 v16, v161, v16
  v_cvt_pk_bf16_f32 v16, v16, v16
  v_and_b32 v16, s36, v16
  v_add_f32 v16, 0, v16
  v_mul_f32 v16, s53, v16
  v_exp_f32 v16, v16
  v_lshlrev_b32 v18, 3, v3
  v_add_f32 v16, 1.0, v16
  v_rcp_f32 v16, v16
  v_mov_b32 v17, s56
  v_cvt_pk_bf16_f32 v16, v16, v16
  v_and_b32 v16, s36, v16
  v_mov_b32 v17, s56
  s_mov_b64 exec, 0xffff
  buffer_store_dwordx2 v[16:17], v18, s[28:31], s50 offen sc1
  s_mov_b64 exec, -1
L_nored:
  s_cmp_eq_u32 s45, 3
  s_cbranch_scc0 L_nopoll
  v_lshrrev_b32 v162, 3, v3
  v_lshlrev_b32 v162, 7, v162
  v_and_b32 v163, 7, v3
  v_lshl_add_u32 v162, v163, 3, v162
  s_lshl_b32 s50, s44, 10
  s_add_u32 s50, s50, 393216
  s_mov_b32 s42, 0
L_wpoll:
  buffer_load_dwordx2 v[16:17], v162, s[28:31], s50 offen sc1
  s_waitcnt vmcnt(0)
  v_cmp_ne_u32 vcc, s56, v17
  s_cbranch_vccz L_wok
  s_sleep 4
  s_add_u32 s42, s42, 1
  s_cmp_lt_u32 s42, 0x20000
  s_cbranch_scc1 L_wpoll
L_wok:
  v_lshl_add_u32 v17, v5, 3, v4
  v_lshlrev_b32 v17, 2, v17
  s_lshl_b32 s50, s44, 8
  v_add_u32 v17, s50, v17
  ds_write_b32 v17, v16 offset:3072
  v_mov_b32 v18, 1
  s_waitcnt lgkmcnt(0)
  s_mov_b64 exec, 1
  ds_write_b32 v160, v18 offset:3980
  s_mov_b64 exec, -1
  s_cmp_eq_u32 s2, 0
  s_cbranch_scc0 L_nopoll
  s_cmp_eq_u32 s44, 2
  s_cbranch_scc0 L_nopoll
  s_mov_b32 s42, 0
L_e0_3:
  ds_read_b32 v166, v7 offset:3980
  s_waitcnt lgkmcnt(0)
  v_readfirstlane_b32 s41, v166
  s_cmp_ge_u32 s41, 1
  s_cbranch_scc1 L_e0ok_4
  s_sleep 1
  s_add_u32 s42, s42, 1
  s_cmp_lt_u32 s42, 0x400000
  s_cbranch_scc1 L_e0_3
L_e0ok_4:
  s_mov_b32 s42, 0
L_e1_5:
  ds_read_b32 v166, v7 offset:3984
  s_waitcnt lgkmcnt(0)
  v_readfirstlane_b32 s41, v166
  s_cmp_ge_u32 s41, 1
  s_cbranch_scc1 L_e1ok_6
  s_sleep 1
  s_add_u32 s42, s42, 1
  s_cmp_lt_u32 s42, 0x400000
  s_cbranch_scc1 L_e1_5
L_e1ok_6:
  v_mov_b32 v18, s56
  s_mov_b32 s50, 397312
  s_mov_b64 exec, 1
  buffer_store_dword v18, off, s[28:31], s50 sc1
  s_mov_b64 exec, -1
L_nopoll:
  s_mov_b32 s42, 0
L_sf_7:
  ds_read_b32 v166, v160 offset:3980
  s_waitcnt lgkmcnt(0)
  v_readfirstlane_b32 s41, v166
  s_cmp_ge_u32 s41, 1
  s_cbranch_scc1 L_sfok_8
  s_sleep 1
  s_add_u32 s42, s42, 1
  s_cmp_lt_u32 s42, 0x400000
  s_cbranch_scc1 L_sf_7
L_sfok_8:
  s_lshl_b32 s50, s44, 8
  v_lshl_add_u32 v16, v5, 5, s50
  ds_read_b128 v[8:11], v16 offset:3072
  ds_read_b128 v[12:15], v16 offset:3088
  s_cmp_eq_u32 s44, 2
  s_cbranch_scc1 L_nogate
  s_mov_b32 s42, 0
L_is_9:
  ds_read_b32 v166, v7 offset:3992
  s_waitcnt lgkmcnt(0)
  v_readfirstlane_b32 s41, v166
  s_cmp_ge_u32 s41, 4
  s_cbranch_scc1 L_isok_10
  s_sleep 1
  s_add_u32 s42, s42, 1
  s_cmp_lt_u32 s42, 0x400000
  s_cbranch_scc1 L_is_9
L_isok_10:
L_nogate:
  s_mov_b32 s38, s37
  s_waitcnt lgkmcnt(0)
  s_getreg_b32 s84, hwreg(HW_REG_XCC_ID)
  s_and_b32 s84, s84, 1
  s_xor_b32 s84, s84, 1
  s_mov_b32 s85, 0
  s_mov_b64 vcc, s[84:85]
L_storecode:
  v_lshlrev_b32 v16, 16, v32
  v_and_b32 v17, s36, v32
  v_mul_f32 v16, v16, v8
  v_mul_f32 v17, v17, v9
  v_lshlrev_b32 v18, 16, v33
  v_and_b32 v19, s36, v33
  v_mul_f32 v18, v18, v10
  v_mul_f32 v19, v19, v11
  v_lshlrev_b32 v20, 16, v34
  v_and_b32 v21, s36, v34
  v_mul_f32 v20, v20, v12
  v_mul_f32 v21, v21, v13
  v_lshlrev_b32 v22, 16, v35
  v_and_b32 v23, s36, v35
  v_mul_f32 v22, v22, v14
  v_mul_f32 v23, v23, v15
  v_cvt_pk_bf16_f32 v32, v16, v17
  v_cvt_pk_bf16_f32 v33, v18, v19
  v_cvt_pk_bf16_f32 v34, v20, v21
  v_cvt_pk_bf16_f32 v35, v22, v23
  s_cbranch_execz L_sk0
  buffer_store_dwordx4 v[32:35], v1, s[20:23], s38 offen sc1
L_sk0:
  s_add_u32 s38, s38, s46
  v_lshlrev_b32 v16, 16, v36
  v_and_b32 v17, s36, v36
  v_mul_f32 v16, v16, v8
  v_mul_f32 v17, v17, v9
  v_lshlrev_b32 v18, 16, v37
  v_and_b32 v19, s36, v37
  v_mul_f32 v18, v18, v10
  v_mul_f32 v19, v19, v11
  v_lshlrev_b32 v20, 16, v38
  v_and_b32 v21, s36, v38
  v_mul_f32 v20, v20, v12
  v_mul_f32 v21, v21, v13
  v_lshlrev_b32 v22, 16, v39
  v_and_b32 v23, s36, v39
  v_mul_f32 v22, v22, v14
  v_mul_f32 v23, v23, v15
  v_cvt_pk_bf16_f32 v36, v16, v17
  v_cvt_pk_bf16_f32 v37, v18, v19
  v_cvt_pk_bf16_f32 v38, v20, v21
  v_cvt_pk_bf16_f32 v39, v22, v23
  s_cbranch_execz L_sk1
  buffer_store_dwordx4 v[36:39], v1, s[20:23], s38 offen sc1
L_sk1:
  s_add_u32 s38, s38, s46
  v_lshlrev_b32 v16, 16, v40
  v_and_b32 v17, s36, v40
  v_mul_f32 v16, v16, v8
  v_mul_f32 v17, v17, v9
  v_lshlrev_b32 v18, 16, v41
  v_and_b32 v19, s36, v41
  v_mul_f32 v18, v18, v10
  v_mul_f32 v19, v19, v11
  v_lshlrev_b32 v20, 16, v42
  v_and_b32 v21, s36, v42
  v_mul_f32 v20, v20, v12
  v_mul_f32 v21, v21, v13
  v_lshlrev_b32 v22, 16, v43
  v_and_b32 v23, s36, v43
  v_mul_f32 v22, v22, v14
  v_mul_f32 v23, v23, v15
  v_cvt_pk_bf16_f32 v40, v16, v17
  v_cvt_pk_bf16_f32 v41, v18, v19
  v_cvt_pk_bf16_f32 v42, v20, v21
  v_cvt_pk_bf16_f32 v43, v22, v23
  s_cbranch_vccz L_ew2
  s_waitcnt vmcnt(1)
L_ew2:
  s_cbranch_execz L_sk2
  buffer_store_dwordx4 v[40:43], v1, s[20:23], s38 offen sc1
L_sk2:
  s_add_u32 s38, s38, s46
  v_lshlrev_b32 v16, 16, v44
  v_and_b32 v17, s36, v44
  v_mul_f32 v16, v16, v8
  v_mul_f32 v17, v17, v9
  v_lshlrev_b32 v18, 16, v45
  v_and_b32 v19, s36, v45
  v_mul_f32 v18, v18, v10
  v_mul_f32 v19, v19, v11
  v_lshlrev_b32 v20, 16, v46
  v_and_b32 v21, s36, v46
  v_mul_f32 v20, v20, v12
  v_mul_f32 v21, v21, v13
  v_lshlrev_b32 v22, 16, v47
  v_and_b32 v23, s36, v47
  v_mul_f32 v22, v22, v14
  v_mul_f32 v23, v23, v15
  v_cvt_pk_bf16_f32 v44, v16, v17
  v_cvt_pk_bf16_f32 v45, v18, v19
  v_cvt_pk_bf16_f32 v46, v20, v21
  v_cvt_pk_bf16_f32 v47, v22, v23
  s_cbranch_vccz L_ew3
  s_waitcnt vmcnt(1)
L_ew3:
  s_cbranch_execz L_sk3
  buffer_store_dwordx4 v[44:47], v1, s[20:23], s38 offen sc1
L_sk3:
  s_add_u32 s38, s38, s46
  v_lshlrev_b32 v16, 16, v48
  v_and_b32 v17, s36, v48
  v_mul_f32 v16, v16, v8
  v_mul_f32 v17, v17, v9
  v_lshlrev_b32 v18, 16, v49
  v_and_b32 v19, s36, v49
  v_mul_f32 v18, v18, v10
  v_mul_f32 v19, v19, v11
  v_lshlrev_b32 v20, 16, v50
  v_and_b32 v21, s36, v50
  v_mul_f32 v20, v20, v12
  v_mul_f32 v21, v21, v13
  v_lshlrev_b32 v22, 16, v51
  v_and_b32 v23, s36, v51
  v_mul_f32 v22, v22, v14
  v_mul_f32 v23, v23, v15
  v_cvt_pk_bf16_f32 v48, v16, v17
  v_cvt_pk_bf16_f32 v49, v18, v19
  v_cvt_pk_bf16_f32 v50, v20, v21
  v_cvt_pk_bf16_f32 v51, v22, v23
  s_cbranch_vccz L_ew4
  s_waitcnt vmcnt(1)
L_ew4:
  s_cbranch_execz L_sk4
  buffer_store_dwordx4 v[48:51], v1, s[20:23], s38 offen sc1
L_sk4:
  s_add_u32 s38, s38, s46
  v_lshlrev_b32 v16, 16, v52
  v_and_b32 v17, s36, v52
  v_mul_f32 v16, v16, v8
  v_mul_f32 v17, v17, v9
  v_lshlrev_b32 v18, 16, v53
  v_and_b32 v19, s36, v53
  v_mul_f32 v18, v18, v10
  v_mul_f32 v19, v19, v11
  v_lshlrev_b32 v20, 16, v54
  v_and_b32 v21, s36, v54
  v_mul_f32 v20, v20, v12
  v_mul_f32 v21, v21, v13
  v_lshlrev_b32 v22, 16, v55
  v_and_b32 v23, s36, v55
  v_mul_f32 v22, v22, v14
  v_mul_f32 v23, v23, v15
  v_cvt_pk_bf16_f32 v52, v16, v17
  v_cvt_pk_bf16_f32 v53, v18, v19
  v_cvt_pk_bf16_f32 v54, v20, v21
  v_cvt_pk_bf16_f32 v55, v22, v23
  s_cbranch_vccz L_ew5
  s_waitcnt vmcnt(1)
L_ew5:
  s_cbranch_execz L_sk5
  buffer_store_dwordx4 v[52:55], v1, s[20:23], s38 offen sc1
L_sk5:
  s_add_u32 s38, s38, s46
  v_lshlrev_b32 v16, 16, v56
  v_and_b32 v17, s36, v56
  v_mul_f32 v16, v16, v8
  v_mul_f32 v17, v17, v9
  v_lshlrev_b32 v18, 16, v57
  v_and_b32 v19, s36, v57
  v_mul_f32 v18, v18, v10
  v_mul_f32 v19, v19, v11
  v_lshlrev_b32 v20, 16, v58
  v_and_b32 v21, s36, v58
  v_mul_f32 v20, v20, v12
  v_mul_f32 v21, v21, v13
  v_lshlrev_b32 v22, 16, v59
  v_and_b32 v23, s36, v59
  v_mul_f32 v22, v22, v14
  v_mul_f32 v23, v23, v15
  v_cvt_pk_bf16_f32 v56, v16, v17
  v_cvt_pk_bf16_f32 v57, v18, v19
  v_cvt_pk_bf16_f32 v58, v20, v21
  v_cvt_pk_bf16_f32 v59, v22, v23
  s_cbranch_vccz L_ew6
  s_waitcnt vmcnt(1)
L_ew6:
  s_cbranch_execz L_sk6
  buffer_store_dwordx4 v[56:59], v1, s[20:23], s38 offen sc1
L_sk6:
  s_add_u32 s38, s38, s46
  v_lshlrev_b32 v16, 16, v60
  v_and_b32 v17, s36, v60
  v_mul_f32 v16, v16, v8
  v_mul_f32 v17, v17, v9
  v_lshlrev_b32 v18, 16, v61
  v_and_b32 v19, s36, v61
  v_mul_f32 v18, v18, v10
  v_mul_f32 v19, v19, v11
  v_lshlrev_b32 v20, 16, v62
  v_and_b32 v21, s36, v62
  v_mul_f32 v20, v20, v12
  v_mul_f32 v21, v21, v13
  v_lshlrev_b32 v22, 16, v63
  v_and_b32 v23, s36, v63
  v_mul_f32 v22, v22, v14
  v_mul_f32 v23, v23, v15
  v_cvt_pk_bf16_f32 v60, v16, v17
  v_cvt_pk_bf16_f32 v61, v18, v19
  v_cvt_pk_bf16_f32 v62, v20, v21
  v_cvt_pk_bf16_f32 v63, v22, v23
  s_cbranch_vccz L_ew7
  s_waitcnt vmcnt(1)
L_ew7:
  s_cbranch_execz L_sk7
  buffer_store_dwordx4 v[60:63], v1, s[20:23], s38 offen sc1
L_sk7:
  s_add_u32 s38, s38, s46
  v_lshlrev_b32 v16, 16, v64
  v_and_b32 v17, s36, v64
  v_mul_f32 v16, v16, v8
  v_mul_f32 v17, v17, v9
  v_lshlrev_b32 v18, 16, v65
  v_and_b32 v19, s36, v65
  v_mul_f32 v18, v18, v10
  v_mul_f32 v19, v19, v11
  v_lshlrev_b32 v20, 16, v66
  v_and_b32 v21, s36, v66
  v_mul_f32 v20, v20, v12
  v_mul_f32 v21, v21, v13
  v_lshlrev_b32 v22, 16, v67
  v_and_b32 v23, s36, v67
  v_mul_f32 v22, v22, v14
  v_mul_f32 v23, v23, v15
  v_cvt_pk_bf16_f32 v64, v16, v17
  v_cvt_pk_bf16_f32 v65, v18, v19
  v_cvt_pk_bf16_f32 v66, v20, v21
  v_cvt_pk_bf16_f32 v67, v22, v23
  s_cbranch_vccz L_ew8
  s_waitcnt vmcnt(1)
L_ew8:
  s_cbranch_execz L_sk8
  buffer_store_dwordx4 v[64:67], v1, s[20:23], s38 offen sc1
L_sk8:
  s_add_u32 s38, s38, s46
  v_lshlrev_b32 v16, 16, v68
  v_and_b32 v17, s36, v68
  v_mul_f32 v16, v16, v8
  v_mul_f32 v17, v17, v9
  v_lshlrev_b32 v18, 16, v69
  v_and_b32 v19, s36, v69
  v_mul_f32 v18, v18, v10
  v_mul_f32 v19, v19, v11
  v_lshlrev_b32 v20, 16, v70
  v_and_b32 v21, s36, v70
  v_mul_f32 v20, v20, v12
  v_mul_f32 v21, v21, v13
  v_lshlrev_b32 v22, 16, v71
  v_and_b32 v23, s36, v71
  v_mul_f32 v22, v22, v14
  v_mul_f32 v23, v23, v15
  v_cvt_pk_bf16_f32 v68, v16, v17
  v_cvt_pk_bf16_f32 v69, v18, v19
  v_cvt_pk_bf16_f32 v70, v20, v21
  v_cvt_pk_bf16_f32 v71, v22, v23
  s_cbranch_vccz L_ew9
  s_waitcnt vmcnt(1)
L_ew9:
  s_cbranch_execz L_sk9
  buffer_store_dwordx4 v[68:71], v1, s[20:23], s38 offen sc1
L_sk9:
  s_add_u32 s38, s38, s46
  v_lshlrev_b32 v16, 16, v72
  v_and_b32 v17, s36, v72
  v_mul_f32 v16, v16, v8
  v_mul_f32 v17, v17, v9
  v_lshlrev_b32 v18, 16, v73
  v_and_b32 v19, s36, v73
  v_mul_f32 v18, v18, v10
  v_mul_f32 v19, v19, v11
  v_lshlrev_b32 v20, 16, v74
  v_and_b32 v21, s36, v74
  v_mul_f32 v20, v20, v12
  v_mul_f32 v21, v21, v13
  v_lshlrev_b32 v22, 16, v75
  v_and_b32 v23, s36, v75
  v_mul_f32 v22, v22, v14
  v_mul_f32 v23, v23, v15
  v_cvt_pk_bf16_f32 v72, v16, v17
  v_cvt_pk_bf16_f32 v73, v18, v19
  v_cvt_pk_bf16_f32 v74, v20, v21
  v_cvt_pk_bf16_f32 v75, v22, v23
  s_cbranch_vccz L_ew10
  s_waitcnt vmcnt(1)
L_ew10:
  s_cbranch_execz L_sk10
  buffer_store_dwordx4 v[72:75], v1, s[20:23], s38 offen sc1
L_sk10:
  s_add_u32 s38, s38, s46
  v_lshlrev_b32 v16, 16, v76
  v_and_b32 v17, s36, v76
  v_mul_f32 v16, v16, v8
  v_mul_f32 v17, v17, v9
  v_lshlrev_b32 v18, 16, v77
  v_and_b32 v19, s36, v77
  v_mul_f32 v18, v18, v10
  v_mul_f32 v19, v19, v11
  v_lshlrev_b32 v20, 16, v78
  v_and_b32 v21, s36, v78
  v_mul_f32 v20, v20, v12
  v_mul_f32 v21, v21, v13
  v_lshlrev_b32 v22, 16, v79
  v_and_b32 v23, s36, v79
  v_mul_f32 v22, v22, v14
  v_mul_f32 v23, v23, v15
  v_cvt_pk_bf16_f32 v76, v16, v17
  v_cvt_pk_bf16_f32 v77, v18, v19
  v_cvt_pk_bf16_f32 v78, v20, v21
  v_cvt_pk_bf16_f32 v79, v22, v23
  s_cbranch_vccz L_ew11
  s_waitcnt vmcnt(1)
L_ew11:
  s_cbranch_execz L_sk11
  buffer_store_dwordx4 v[76:79], v1, s[20:23], s38 offen sc1
L_sk11:
  s_add_u32 s38, s38, s46
  v_lshlrev_b32 v16, 16, v80
  v_and_b32 v17, s36, v80
  v_mul_f32 v16, v16, v8
  v_mul_f32 v17, v17, v9
  v_lshlrev_b32 v18, 16, v81
  v_and_b32 v19, s36, v81
  v_mul_f32 v18, v18, v10
  v_mul_f32 v19, v19, v11
  v_lshlrev_b32 v20, 16, v82
  v_and_b32 v21, s36, v82
  v_mul_f32 v20, v20, v12
  v_mul_f32 v21, v21, v13
  v_lshlrev_b32 v22, 16, v83
  v_and_b32 v23, s36, v83
  v_mul_f32 v22, v22, v14
  v_mul_f32 v23, v23, v15
  v_cvt_pk_bf16_f32 v80, v16, v17
  v_cvt_pk_bf16_f32 v81, v18, v19
  v_cvt_pk_bf16_f32 v82, v20, v21
  v_cvt_pk_bf16_f32 v83, v22, v23
  s_cbranch_vccz L_ew12
  s_waitcnt vmcnt(1)
L_ew12:
  s_cbranch_execz L_sk12
  buffer_store_dwordx4 v[80:83], v1, s[20:23], s38 offen sc1
L_sk12:
  s_add_u32 s38, s38, s46
  v_lshlrev_b32 v16, 16, v84
  v_and_b32 v17, s36, v84
  v_mul_f32 v16, v16, v8
  v_mul_f32 v17, v17, v9
  v_lshlrev_b32 v18, 16, v85
  v_and_b32 v19, s36, v85
  v_mul_f32 v18, v18, v10
  v_mul_f32 v19, v19, v11
  v_lshlrev_b32 v20, 16, v86
  v_and_b32 v21, s36, v86
  v_mul_f32 v20, v20, v12
  v_mul_f32 v21, v21, v13
  v_lshlrev_b32 v22, 16, v87
  v_and_b32 v23, s36, v87
  v_mul_f32 v22, v22, v14
  v_mul_f32 v23, v23, v15
  v_cvt_pk_bf16_f32 v84, v16, v17
  v_cvt_pk_bf16_f32 v85, v18, v19
  v_cvt_pk_bf16_f32 v86, v20, v21
  v_cvt_pk_bf16_f32 v87, v22, v23
  s_cbranch_vccz L_ew13
  s_waitcnt vmcnt(1)
L_ew13:
  s_cbranch_execz L_sk13
  buffer_store_dwordx4 v[84:87], v1, s[20:23], s38 offen sc1
L_sk13:
  s_add_u32 s38, s38, s46
  v_lshlrev_b32 v16, 16, v88
  v_and_b32 v17, s36, v88
  v_mul_f32 v16, v16, v8
  v_mul_f32 v17, v17, v9
  v_lshlrev_b32 v18, 16, v89
  v_and_b32 v19, s36, v89
  v_mul_f32 v18, v18, v10
  v_mul_f32 v19, v19, v11
  v_lshlrev_b32 v20, 16, v90
  v_and_b32 v21, s36, v90
  v_mul_f32 v20, v20, v12
  v_mul_f32 v21, v21, v13
  v_lshlrev_b32 v22, 16, v91
  v_and_b32 v23, s36, v91
  v_mul_f32 v22, v22, v14
  v_mul_f32 v23, v23, v15
  v_cvt_pk_bf16_f32 v88, v16, v17
  v_cvt_pk_bf16_f32 v89, v18, v19
  v_cvt_pk_bf16_f32 v90, v20, v21
  v_cvt_pk_bf16_f32 v91, v22, v23
  s_cbranch_vccz L_ew14
  s_waitcnt vmcnt(1)
L_ew14:
  s_cbranch_execz L_sk14
  buffer_store_dwordx4 v[88:91], v1, s[20:23], s38 offen sc1
L_sk14:
  s_add_u32 s38, s38, s46
  v_lshlrev_b32 v16, 16, v92
  v_and_b32 v17, s36, v92
  v_mul_f32 v16, v16, v8
  v_mul_f32 v17, v17, v9
  v_lshlrev_b32 v18, 16, v93
  v_and_b32 v19, s36, v93
  v_mul_f32 v18, v18, v10
  v_mul_f32 v19, v19, v11
  v_lshlrev_b32 v20, 16, v94
  v_and_b32 v21, s36, v94
  v_mul_f32 v20, v20, v12
  v_mul_f32 v21, v21, v13
  v_lshlrev_b32 v22, 16, v95
  v_and_b32 v23, s36, v95
  v_mul_f32 v22, v22, v14
  v_mul_f32 v23, v23, v15
  v_cvt_pk_bf16_f32 v92, v16, v17
  v_cvt_pk_bf16_f32 v93, v18, v19
  v_cvt_pk_bf16_f32 v94, v20, v21
  v_cvt_pk_bf16_f32 v95, v22, v23
  s_cbranch_vccz L_ew15
  s_waitcnt vmcnt(1)
L_ew15:
  s_cbranch_execz L_sk15
  buffer_store_dwordx4 v[92:95], v1, s[20:23], s38 offen sc1
L_sk15:
  s_add_u32 s38, s38, s46
  v_lshlrev_b32 v16, 16, v96
  v_and_b32 v17, s36, v96
  v_mul_f32 v16, v16, v8
  v_mul_f32 v17, v17, v9
  v_lshlrev_b32 v18, 16, v97
  v_and_b32 v19, s36, v97
  v_mul_f32 v18, v18, v10
  v_mul_f32 v19, v19, v11
  v_lshlrev_b32 v20, 16, v98
  v_and_b32 v21, s36, v98
  v_mul_f32 v20, v20, v12
  v_mul_f32 v21, v21, v13
  v_lshlrev_b32 v22, 16, v99
  v_and_b32 v23, s36, v99
  v_mul_f32 v22, v22, v14
  v_mul_f32 v23, v23, v15
  v_cvt_pk_bf16_f32 v96, v16, v17
  v_cvt_pk_bf16_f32 v97, v18, v19
  v_cvt_pk_bf16_f32 v98, v20, v21
  v_cvt_pk_bf16_f32 v99, v22, v23
  s_cbranch_vccz L_ew16
  s_waitcnt vmcnt(2)
L_ew16:
  s_cbranch_execz L_sk16
  buffer_store_dwordx4 v[96:99], v1, s[20:23], s38 offen sc1
L_sk16:
  s_add_u32 s38, s38, s46
  v_lshlrev_b32 v16, 16, v100
  v_and_b32 v17, s36, v100
  v_mul_f32 v16, v16, v8
  v_mul_f32 v17, v17, v9
  v_lshlrev_b32 v18, 16, v101
  v_and_b32 v19, s36, v101
  v_mul_f32 v18, v18, v10
  v_mul_f32 v19, v19, v11
  v_lshlrev_b32 v20, 16, v102
  v_and_b32 v21, s36, v102
  v_mul_f32 v20, v20, v12
  v_mul_f32 v21, v21, v13
  v_lshlrev_b32 v22, 16, v103
  v_and_b32 v23, s36, v103
  v_mul_f32 v22, v22, v14
  v_mul_f32 v23, v23, v15
  v_cvt_pk_bf16_f32 v100, v16, v17
  v_cvt_pk_bf16_f32 v101, v18, v19
  v_cvt_pk_bf16_f32 v102, v20, v21
  v_cvt_pk_bf16_f32 v103, v22, v23
  s_cbranch_vccz L_ew17
  s_waitcnt vmcnt(2)
L_ew17:
  s_cbranch_execz L_sk17
  buffer_store_dwordx4 v[100:103], v1, s[20:23], s38 offen sc1
L_sk17:
  s_add_u32 s38, s38, s46
  v_lshlrev_b32 v16, 16, v104
  v_and_b32 v17, s36, v104
  v_mul_f32 v16, v16, v8
  v_mul_f32 v17, v17, v9
  v_lshlrev_b32 v18, 16, v105
  v_and_b32 v19, s36, v105
  v_mul_f32 v18, v18, v10
  v_mul_f32 v19, v19, v11
  v_lshlrev_b32 v20, 16, v106
  v_and_b32 v21, s36, v106
  v_mul_f32 v20, v20, v12
  v_mul_f32 v21, v21, v13
  v_lshlrev_b32 v22, 16, v107
  v_and_b32 v23, s36, v107
  v_mul_f32 v22, v22, v14
  v_mul_f32 v23, v23, v15
  v_cvt_pk_bf16_f32 v104, v16, v17
  v_cvt_pk_bf16_f32 v105, v18, v19
  v_cvt_pk_bf16_f32 v106, v20, v21
  v_cvt_pk_bf16_f32 v107, v22, v23
  s_cbranch_vccz L_ew18
  s_waitcnt vmcnt(2)
L_ew18:
  s_cbranch_execz L_sk18
  buffer_store_dwordx4 v[104:107], v1, s[20:23], s38 offen sc1
L_sk18:
  s_add_u32 s38, s38, s46
  v_lshlrev_b32 v16, 16, v108
  v_and_b32 v17, s36, v108
  v_mul_f32 v16, v16, v8
  v_mul_f32 v17, v17, v9
  v_lshlrev_b32 v18, 16, v109
  v_and_b32 v19, s36, v109
  v_mul_f32 v18, v18, v10
  v_mul_f32 v19, v19, v11
  v_lshlrev_b32 v20, 16, v110
  v_and_b32 v21, s36, v110
  v_mul_f32 v20, v20, v12
  v_mul_f32 v21, v21, v13
  v_lshlrev_b32 v22, 16, v111
  v_and_b32 v23, s36, v111
  v_mul_f32 v22, v22, v14
  v_mul_f32 v23, v23, v15
  v_cvt_pk_bf16_f32 v108, v16, v17
  v_cvt_pk_bf16_f32 v109, v18, v19
  v_cvt_pk_bf16_f32 v110, v20, v21
  v_cvt_pk_bf16_f32 v111, v22, v23
  s_cbranch_vccz L_ew19
  s_waitcnt vmcnt(2)
L_ew19:
  s_cbranch_execz L_sk19
  buffer_store_dwordx4 v[108:111], v1, s[20:23], s38 offen sc1
L_sk19:
  s_add_u32 s38, s38, s46
  v_lshlrev_b32 v16, 16, v112
  v_and_b32 v17, s36, v112
  v_mul_f32 v16, v16, v8
  v_mul_f32 v17, v17, v9
  v_lshlrev_b32 v18, 16, v113
  v_and_b32 v19, s36, v113
  v_mul_f32 v18, v18, v10
  v_mul_f32 v19, v19, v11
  v_lshlrev_b32 v20, 16, v114
  v_and_b32 v21, s36, v114
  v_mul_f32 v20, v20, v12
  v_mul_f32 v21, v21, v13
  v_lshlrev_b32 v22, 16, v115
  v_and_b32 v23, s36, v115
  v_mul_f32 v22, v22, v14
  v_mul_f32 v23, v23, v15
  v_cvt_pk_bf16_f32 v112, v16, v17
  v_cvt_pk_bf16_f32 v113, v18, v19
  v_cvt_pk_bf16_f32 v114, v20, v21
  v_cvt_pk_bf16_f32 v115, v22, v23
  s_cbranch_vccz L_ew20
  s_waitcnt vmcnt(2)
L_ew20:
  s_cbranch_execz L_sk20
  buffer_store_dwordx4 v[112:115], v1, s[20:23], s38 offen sc1
L_sk20:
  s_add_u32 s38, s38, s46
  v_lshlrev_b32 v16, 16, v116
  v_and_b32 v17, s36, v116
  v_mul_f32 v16, v16, v8
  v_mul_f32 v17, v17, v9
  v_lshlrev_b32 v18, 16, v117
  v_and_b32 v19, s36, v117
  v_mul_f32 v18, v18, v10
  v_mul_f32 v19, v19, v11
  v_lshlrev_b32 v20, 16, v118
  v_and_b32 v21, s36, v118
  v_mul_f32 v20, v20, v12
  v_mul_f32 v21, v21, v13
  v_lshlrev_b32 v22, 16, v119
  v_and_b32 v23, s36, v119
  v_mul_f32 v22, v22, v14
  v_mul_f32 v23, v23, v15
  v_cvt_pk_bf16_f32 v116, v16, v17
  v_cvt_pk_bf16_f32 v117, v18, v19
  v_cvt_pk_bf16_f32 v118, v20, v21
  v_cvt_pk_bf16_f32 v119, v22, v23
  s_cbranch_vccz L_ew21
  s_waitcnt vmcnt(2)
L_ew21:
  s_cbranch_execz L_sk21
  buffer_store_dwordx4 v[116:119], v1, s[20:23], s38 offen sc1
L_sk21:
  s_add_u32 s38, s38, s46
  v_lshlrev_b32 v16, 16, v120
  v_and_b32 v17, s36, v120
  v_mul_f32 v16, v16, v8
  v_mul_f32 v17, v17, v9
  v_lshlrev_b32 v18, 16, v121
  v_and_b32 v19, s36, v121
  v_mul_f32 v18, v18, v10
  v_mul_f32 v19, v19, v11
  v_lshlrev_b32 v20, 16, v122
  v_and_b32 v21, s36, v122
  v_mul_f32 v20, v20, v12
  v_mul_f32 v21, v21, v13
  v_lshlrev_b32 v22, 16, v123
  v_and_b32 v23, s36, v123
  v_mul_f32 v22, v22, v14
  v_mul_f32 v23, v23, v15
  v_cvt_pk_bf16_f32 v120, v16, v17
  v_cvt_pk_bf16_f32 v121, v18, v19
  v_cvt_pk_bf16_f32 v122, v20, v21
  v_cvt_pk_bf16_f32 v123, v22, v23
  s_cbranch_vccz L_ew22
  s_waitcnt vmcnt(2)
L_ew22:
  s_cbranch_execz L_sk22
  buffer_store_dwordx4 v[120:123], v1, s[20:23], s38 offen sc1
L_sk22:
  s_add_u32 s38, s38, s46
  v_lshlrev_b32 v16, 16, v124
  v_and_b32 v17, s36, v124
  v_mul_f32 v16, v16, v8
  v_mul_f32 v17, v17, v9
  v_lshlrev_b32 v18, 16, v125
  v_and_b32 v19, s36, v125
  v_mul_f32 v18, v18, v10
  v_mul_f32 v19, v19, v11
  v_lshlrev_b32 v20, 16, v126
  v_and_b32 v21, s36, v126
  v_mul_f32 v20, v20, v12
  v_mul_f32 v21, v21, v13
  v_lshlrev_b32 v22, 16, v127
  v_and_b32 v23, s36, v127
  v_mul_f32 v22, v22, v14
  v_mul_f32 v23, v23, v15
  v_cvt_pk_bf16_f32 v124, v16, v17
  v_cvt_pk_bf16_f32 v125, v18, v19
  v_cvt_pk_bf16_f32 v126, v20, v21
  v_cvt_pk_bf16_f32 v127, v22, v23
  s_cbranch_vccz L_ew23
  s_waitcnt vmcnt(2)
L_ew23:
  s_cbranch_execz L_sk23
  buffer_store_dwordx4 v[124:127], v1, s[20:23], s38 offen sc1
L_sk23:
  s_add_u32 s38, s38, s46
  v_lshlrev_b32 v16, 16, v128
  v_and_b32 v17, s36, v128
  v_mul_f32 v16, v16, v8
  v_mul_f32 v17, v17, v9
  v_lshlrev_b32 v18, 16, v129
  v_and_b32 v19, s36, v129
  v_mul_f32 v18, v18, v10
  v_mul_f32 v19, v19, v11
  v_lshlrev_b32 v20, 16, v130
  v_and_b32 v21, s36, v130
  v_mul_f32 v20, v20, v12
  v_mul_f32 v21, v21, v13
  v_lshlrev_b32 v22, 16, v131
  v_and_b32 v23, s36, v131
  v_mul_f32 v22, v22, v14
  v_mul_f32 v23, v23, v15
  v_cvt_pk_bf16_f32 v128, v16, v17
  v_cvt_pk_bf16_f32 v129, v18, v19
  v_cvt_pk_bf16_f32 v130, v20, v21
  v_cvt_pk_bf16_f32 v131, v22, v23
  s_cbranch_vccz L_ew24
  s_waitcnt vmcnt(2)
L_ew24:
  s_cbranch_execz L_sk24
  buffer_store_dwordx4 v[128:131], v1, s[20:23], s38 offen sc1
L_sk24:
  s_add_u32 s38, s38, s46
  v_lshlrev_b32 v16, 16, v132
  v_and_b32 v17, s36, v132
  v_mul_f32 v16, v16, v8
  v_mul_f32 v17, v17, v9
  v_lshlrev_b32 v18, 16, v133
  v_and_b32 v19, s36, v133
  v_mul_f32 v18, v18, v10
  v_mul_f32 v19, v19, v11
  v_lshlrev_b32 v20, 16, v134
  v_and_b32 v21, s36, v134
  v_mul_f32 v20, v20, v12
  v_mul_f32 v21, v21, v13
  v_lshlrev_b32 v22, 16, v135
  v_and_b32 v23, s36, v135
  v_mul_f32 v22, v22, v14
  v_mul_f32 v23, v23, v15
  v_cvt_pk_bf16_f32 v132, v16, v17
  v_cvt_pk_bf16_f32 v133, v18, v19
  v_cvt_pk_bf16_f32 v134, v20, v21
  v_cvt_pk_bf16_f32 v135, v22, v23
  s_cbranch_vccz L_ew25
  s_waitcnt vmcnt(2)
L_ew25:
  s_cbranch_execz L_sk25
  buffer_store_dwordx4 v[132:135], v1, s[20:23], s38 offen sc1
L_sk25:
  s_add_u32 s38, s38, s46
  v_lshlrev_b32 v16, 16, v136
  v_and_b32 v17, s36, v136
  v_mul_f32 v16, v16, v8
  v_mul_f32 v17, v17, v9
  v_lshlrev_b32 v18, 16, v137
  v_and_b32 v19, s36, v137
  v_mul_f32 v18, v18, v10
  v_mul_f32 v19, v19, v11
  v_lshlrev_b32 v20, 16, v138
  v_and_b32 v21, s36, v138
  v_mul_f32 v20, v20, v12
  v_mul_f32 v21, v21, v13
  v_lshlrev_b32 v22, 16, v139
  v_and_b32 v23, s36, v139
  v_mul_f32 v22, v22, v14
  v_mul_f32 v23, v23, v15
  v_cvt_pk_bf16_f32 v136, v16, v17
  v_cvt_pk_bf16_f32 v137, v18, v19
  v_cvt_pk_bf16_f32 v138, v20, v21
  v_cvt_pk_bf16_f32 v139, v22, v23
  s_cbranch_vccz L_ew26
  s_waitcnt vmcnt(2)
L_ew26:
  s_cbranch_execz L_sk26
  buffer_store_dwordx4 v[136:139], v1, s[20:23], s38 offen sc1
L_sk26:
  s_add_u32 s38, s38, s46
  v_lshlrev_b32 v16, 16, v140
  v_and_b32 v17, s36, v140
  v_mul_f32 v16, v16, v8
  v_mul_f32 v17, v17, v9
  v_lshlrev_b32 v18, 16, v141
  v_and_b32 v19, s36, v141
  v_mul_f32 v18, v18, v10
  v_mul_f32 v19, v19, v11
  v_lshlrev_b32 v20, 16, v142
  v_and_b32 v21, s36, v142
  v_mul_f32 v20, v20, v12
  v_mul_f32 v21, v21, v13
  v_lshlrev_b32 v22, 16, v143
  v_and_b32 v23, s36, v143
  v_mul_f32 v22, v22, v14
  v_mul_f32 v23, v23, v15
  v_cvt_pk_bf16_f32 v140, v16, v17
  v_cvt_pk_bf16_f32 v141, v18, v19
  v_cvt_pk_bf16_f32 v142, v20, v21
  v_cvt_pk_bf16_f32 v143, v22, v23
  s_cbranch_vccz L_ew27
  s_waitcnt vmcnt(2)
L_ew27:
  s_cbranch_execz L_sk27
  buffer_store_dwordx4 v[140:143], v1, s[20:23], s38 offen sc1
L_sk27:
  s_add_u32 s38, s38, s46
  v_lshlrev_b32 v16, 16, v144
  v_and_b32 v17, s36, v144
  v_mul_f32 v16, v16, v8
  v_mul_f32 v17, v17, v9
  v_lshlrev_b32 v18, 16, v145
  v_and_b32 v19, s36, v145
  v_mul_f32 v18, v18, v10
  v_mul_f32 v19, v19, v11
  v_lshlrev_b32 v20, 16, v146
  v_and_b32 v21, s36, v146
  v_mul_f32 v20, v20, v12
  v_mul_f32 v21, v21, v13
  v_lshlrev_b32 v22, 16, v147
  v_and_b32 v23, s36, v147
  v_mul_f32 v22, v22, v14
  v_mul_f32 v23, v23, v15
  v_cvt_pk_bf16_f32 v144, v16, v17
  v_cvt_pk_bf16_f32 v145, v18, v19
  v_cvt_pk_bf16_f32 v146, v20, v21
  v_cvt_pk_bf16_f32 v147, v22, v23
  s_cbranch_vccz L_ew28
  s_waitcnt vmcnt(2)
L_ew28:
  s_cbranch_execz L_sk28
  buffer_store_dwordx4 v[144:147], v1, s[20:23], s38 offen sc1
L_sk28:
  s_add_u32 s38, s38, s46
  v_lshlrev_b32 v16, 16, v148
  v_and_b32 v17, s36, v148
  v_mul_f32 v16, v16, v8
  v_mul_f32 v17, v17, v9
  v_lshlrev_b32 v18, 16, v149
  v_and_b32 v19, s36, v149
  v_mul_f32 v18, v18, v10
  v_mul_f32 v19, v19, v11
  v_lshlrev_b32 v20, 16, v150
  v_and_b32 v21, s36, v150
  v_mul_f32 v20, v20, v12
  v_mul_f32 v21, v21, v13
  v_lshlrev_b32 v22, 16, v151
  v_and_b32 v23, s36, v151
  v_mul_f32 v22, v22, v14
  v_mul_f32 v23, v23, v15
  v_cvt_pk_bf16_f32 v148, v16, v17
  v_cvt_pk_bf16_f32 v149, v18, v19
  v_cvt_pk_bf16_f32 v150, v20, v21
  v_cvt_pk_bf16_f32 v151, v22, v23
  s_cbranch_vccz L_ew29
  s_waitcnt vmcnt(2)
L_ew29:
  s_cbranch_execz L_sk29
  buffer_store_dwordx4 v[148:151], v1, s[20:23], s38 offen sc1
L_sk29:
  s_add_u32 s38, s38, s46
  v_lshlrev_b32 v16, 16, v152
  v_and_b32 v17, s36, v152
  v_mul_f32 v16, v16, v8
  v_mul_f32 v17, v17, v9
  v_lshlrev_b32 v18, 16, v153
  v_and_b32 v19, s36, v153
  v_mul_f32 v18, v18, v10
  v_mul_f32 v19, v19, v11
  v_lshlrev_b32 v20, 16, v154
  v_and_b32 v21, s36, v154
  v_mul_f32 v20, v20, v12
  v_mul_f32 v21, v21, v13
  v_lshlrev_b32 v22, 16, v155
  v_and_b32 v23, s36, v155
  v_mul_f32 v22, v22, v14
  v_mul_f32 v23, v23, v15
  v_cvt_pk_bf16_f32 v152, v16, v17
  v_cvt_pk_bf16_f32 v153, v18, v19
  v_cvt_pk_bf16_f32 v154, v20, v21
  v_cvt_pk_bf16_f32 v155, v22, v23
  s_cbranch_vccz L_ew30
  s_waitcnt vmcnt(2)
L_ew30:
  s_cbranch_execz L_sk30
  buffer_store_dwordx4 v[152:155], v1, s[20:23], s38 offen sc1
L_sk30:
  s_add_u32 s38, s38, s46
  v_lshlrev_b32 v16, 16, v156
  v_and_b32 v17, s36, v156
  v_mul_f32 v16, v16, v8
  v_mul_f32 v17, v17, v9
  v_lshlrev_b32 v18, 16, v157
  v_and_b32 v19, s36, v157
  v_mul_f32 v18, v18, v10
  v_mul_f32 v19, v19, v11
  v_lshlrev_b32 v20, 16, v158
  v_and_b32 v21, s36, v158
  v_mul_f32 v20, v20, v12
  v_mul_f32 v21, v21, v13
  v_lshlrev_b32 v22, 16, v159
  v_and_b32 v23, s36, v159
  v_mul_f32 v22, v22, v14
  v_mul_f32 v23, v23, v15
  v_cvt_pk_bf16_f32 v156, v16, v17
  v_cvt_pk_bf16_f32 v157, v18, v19
  v_cvt_pk_bf16_f32 v158, v20, v21
  v_cvt_pk_bf16_f32 v159, v22, v23
  s_cbranch_vccz L_ew31
  s_waitcnt vmcnt(2)
L_ew31:
  s_cbranch_execz L_sk31
  buffer_store_dwordx4 v[156:159], v1, s[20:23], s38 offen sc1
L_sk31:
  s_cmp_eq_u32 s83, 1
  s_cbranch_scc1 L_dryback
L_fin:
L_end:
  s_endpgm
.section .rodata,"a"
.p2align 6
.amdhsa_kernel standalone__channel_attn_eca__vision_kernel
  .amdhsa_next_free_vgpr 168
  .amdhsa_next_free_sgpr 96
  .amdhsa_accum_offset 168
  .amdhsa_group_segment_fixed_size 0
  .amdhsa_kernarg_size 40
  .amdhsa_user_sgpr_count 2
  .amdhsa_user_sgpr_kernarg_segment_ptr 1
  .amdhsa_system_sgpr_workgroup_id_x 1
  .amdhsa_float_denorm_mode_32 3
.end_amdhsa_kernel
```
